```python
import torch

def _softmax(x, axis=-1):
    return torch.softmax(x, dim=axis)
def _gelu(x):
    return torch.nn.functional.gelu(x, approximate="tanh")
def _silu(x):
    return torch.nn.functional.silu(x)
def _sigmoid(x):
    return torch.sigmoid(x)
def _layernorm(x, axis=-1, eps=1e-5):
    m = x.mean(dim=axis, keepdim=True)
    v = x.var(dim=axis, keepdim=True, unbiased=False)
    return (x - m) / torch.sqrt(v + eps)
def _scatter_add(tgt, idx, src, axis=0):
    return tgt.clone().index_add_(axis, idx, src)
def _segment_sum(src, seg, n):
    out = torch.zeros((n,) + src.shape[1:], dtype=src.dtype)
    return out.index_add_(0, seg, src)
def _pad(x, pw):
    flat = tuple(v for pair in reversed(pw) for v in pair)
    return torch.nn.functional.pad(x, flat)

kernel_name = 'standalone__kernel_systems_refs_featgraph__graph'

def setup_inputs():

    _w = (lambda a: (lambda t: t.to(torch.bfloat16) if t.is_floating_point() else t)(torch.as_tensor(a)))
    N, deg, D = 25000, 32, 64
    E = N * deg
    scale = D ** -0.5
    src = (lambda lo, hi, *s: torch.randint(lo, hi, s))(0, N, E).to(torch.int64)
    dst = (lambda lo, hi, *s: torch.randint(lo, hi, s))(0, N, E).to(torch.int64)
    return {
        "x": _w((lambda *s: torch.randn(*s, dtype=torch.bfloat16) * 0.8)(N, D)),
        "src": _w(src),
        "dst": _w(dst),
        "w_q": _w((lambda *s: torch.randn(*s, dtype=torch.bfloat16) * 0.8)(D, D) * scale),
        "w_v": _w((lambda *s: torch.randn(*s, dtype=torch.bfloat16) * 0.05)(D, D) * scale),
    }

def reference(x, src, dst, w_q, w_v):
    N, D = x.shape
    xs = x[src]
    xd = x[dst]
    q = xd @ w_q
    logits = torch.einsum('ed,ed->e', xs, q) * (float(D) ** -0.5)
    alpha = _sigmoid(logits)
    msg = alpha[:, None] * (xs @ w_v)
    return _segment_sum(msg, dst, N)
```

```asm
; @launch grid=(256,1,1) block=(1024,1,1) lds=160000
.amdgcn_target "amdgcn-amd-amdhsa--gfx950"
.text
.globl standalone__kernel_systems_refs_featgraph__graph_kernel
.p2align 8
.type standalone__kernel_systems_refs_featgraph__graph_kernel,@function
standalone__kernel_systems_refs_featgraph__graph_kernel:
    s_cmp_ge_u32 s2, 256
    s_cbranch_scc1 L_done
    s_load_dwordx4 s[16:19], s[0:1], 8
    s_load_dwordx2 s[8:9], s[0:1], 56
    v_readfirstlane_b32 s3, v0
    v_lshlrev_b32 v1, 4, v0
    v_mov_b32 v64, 0x7f07fff
    s_lshr_b32 s3, s3, 6
    v_mov_b32 v65, v64
    v_mov_b32 v66, v64
    v_mov_b32 v67, v64
    s_cmp_eq_u32 s3, 15
    s_cbranch_scc1 L_w15
    s_mul_i32 s76, s2, 12544
    ds_write_b128 v1, v[64:67] offset:8448
    ds_write_b128 v1, v[64:67] offset:24832
    v_mov_b32 v5, 0
    v_lshlrev_b32 v6, 2, v0
    s_movk_i32 s77, 784
    s_cmp_eq_u32 s2, 255
    s_cselect_b32 s77, 80, s77
    ds_write_b32 v6, v5 offset:41216
    v_add_u32 v4, s76, v1
    v_cmp_gt_u32 s[74:75], s77, v0
    s_cmp_lg_u32 s3, 14
    s_cbranch_scc1 L_not14
    ds_write_b128 v1, v[64:67] offset:9472
    ds_write_b128 v1, v[64:67] offset:25856
L_not14:
    s_waitcnt lgkmcnt(0)
    s_mov_b64 exec, s[74:75]
    s_cbranch_execz L_noload
    global_load_dwordx4 v[80:83], v4, s[18:19]
    global_load_dwordx4 v[84:87], v4, s[16:17]
    s_branch L_noload
L_w15:
    s_getpc_b64 s[76:77]
    v_and_b32 v7, 63, v0
    v_lshlrev_b32 v7, 7, v7
    s_mov_b32 exec_hi, 0x3ffff
    global_load_dword v119, v7, s[76:77]
    s_waitcnt lgkmcnt(0)
    s_load_dword s40, s[8:9], 0
L_noload:
    s_mov_b64 exec, -1
    s_barrier
    s_load_dwordx2 s[4:5], s[0:1], 0
    s_load_dwordx4 s[20:23], s[0:1], 24
    s_load_dwordx2 s[12:13], s[0:1], 40
    v_add_u32 v7, 139520, v1
    ds_write_b128 v7, v[64:67]
    s_cmp_ge_u32 s3, 4
    s_cbranch_scc1 L_init_done
    ds_write_b128 v7, v[64:67] offset:16384
    s_cmp_lg_u32 s3, 0
    s_cbranch_scc1 L_init_done
    s_movk_i32 s76, 320
    v_mov_b32 v7, 139520
    v_mad_u32_u24 v7, v6, s76, v7
    v_cmp_gt_u32 vcc, 16, v0
    s_nop 1
    v_cndmask_b32 v7, 0, v7, vcc
    ds_write_b32 v6, v7 offset:8192
L_init_done:
    s_mov_b32 s10, 268435456
    s_mov_b32 s11, 0x20000
    v_mov_b32 v2, 4
    v_bfe_u32 v5, v0, 3, 3
    v_and_b32 v6, 4, v0
    v_lshl_or_b32 v5, v6, 1, v5
    s_lshl_b32 s76, s3, 4
    v_or_b32 v4, s76, v5
    v_lshlrev_b32 v110, 2, v4
    v_and_b32 v6, 0x30, v1
    s_movk_i32 s78, 0x70
    v_bitop3_b32 v6, v110, v6, s78 bitop3:0x28
    v_lshl_or_b32 v108, v4, 7, v6
    v_xor_b32 v109, 64, v108
    s_mov_b32 s6, 3200000
    s_mov_b32 s7, 0x20000
    s_lshl_b32 s47, s2, 7
    s_mul_i32 s72, s2, 16640
    s_add_u32 s73, s72, 6291456
    s_add_u32 s72, s72, 4096
    s_movk_i32 s79, 0x7f
    s_movk_i32 s80, 0x3f0
    s_cmp_ge_u32 s3, 13
    s_cbranch_scc1 L_table
    s_mov_b64 exec, s[74:75]
    s_cbranch_execz L_p1skip
    s_waitcnt vmcnt(1)
    v_lshlrev_b32_sdwa v88, 2, v80 dst_sel:DWORD dst_unused:UNUSED_PAD src0_sel:DWORD src1_sel:BYTE_0
    ds_add_rtn_u32 v92, v88, v2 offset:41216
    v_lshlrev_b32_sdwa v89, 2, v81 dst_sel:DWORD dst_unused:UNUSED_PAD src0_sel:DWORD src1_sel:BYTE_0
    ds_add_rtn_u32 v93, v89, v2 offset:41216
    v_lshlrev_b32_sdwa v90, 2, v82 dst_sel:DWORD dst_unused:UNUSED_PAD src0_sel:DWORD src1_sel:BYTE_0
    ds_add_rtn_u32 v94, v90, v2 offset:41216
    v_lshlrev_b32_sdwa v91, 2, v83 dst_sel:DWORD dst_unused:UNUSED_PAD src0_sel:DWORD src1_sel:BYTE_0
    ds_add_rtn_u32 v95, v91, v2 offset:41216
    s_waitcnt vmcnt(0)
    v_lshrrev_b32 v80, 8, v80
    v_lshl_or_b32 v80, v80, 20, v84
    v_and_b32 v84, s80, v88
    v_lshrrev_b32 v81, 8, v81
    v_lshl_or_b32 v81, v81, 20, v85
    v_and_b32 v85, s80, v89
    v_lshrrev_b32 v82, 8, v82
    v_lshl_or_b32 v82, v82, 20, v86
    v_and_b32 v86, s80, v90
    v_lshrrev_b32 v83, 8, v83
    v_lshl_or_b32 v83, v83, 20, v87
    v_and_b32 v87, s80, v91
    s_waitcnt lgkmcnt(0)
    v_bitop3_b32 v92, v92, v84, s79 bitop3:0x28
    v_lshl_or_b32 v92, v88, 5, v92
    ds_write_b32 v92, v80 offset:8448
    v_bitop3_b32 v93, v93, v85, s79 bitop3:0x28
    v_lshl_or_b32 v93, v89, 5, v93
    ds_write_b32 v93, v81 offset:8448
    v_bitop3_b32 v94, v94, v86, s79 bitop3:0x28
    v_lshl_or_b32 v94, v90, 5, v94
    ds_write_b32 v94, v82 offset:8448
    v_bitop3_b32 v95, v95, v87, s79 bitop3:0x28
    v_lshl_or_b32 v95, v91, 5, v95
    ds_write_b32 v95, v83 offset:8448
L_p1skip:
    s_mov_b64 exec, -1
    s_setprio 3
    s_waitcnt lgkmcnt(0)
    s_barrier
    ds_read_b32 v4, v110 offset:41216
    ds_read_b128 v[120:123], v2 offset:45308
    ds_read_b128 v[80:83], v108 offset:8448
    ds_read_b128 v[28:31], v109 offset:8448
    s_waitcnt lgkmcnt(3)
    v_cmp_lt_u32 vcc, 128, v4
    v_cmp_le_u32 s[42:43], 64, v4
    s_waitcnt lgkmcnt(1)
    s_cbranch_vccnz L_slotfull
L_slotok:
    v_xor_b32 v80, v120, v80
    v_xor_b32 v81, v121, v81
    v_xor_b32 v82, v122, v82
    v_xor_b32 v83, v123, v83
    buffer_store_dwordx4 v[80:83], v1, s[8:11], s72 offen sc1
    s_setprio 0
    v_and_b32 v4, s80, v1
    v_add_u32 v4, 65792, v4
    ds_read_b128 v[8:11], v4
    ds_read_b128 v[12:15], v4 offset:1024
    ds_read_b128 v[16:19], v4 offset:2048
    ds_read_b128 v[20:23], v4 offset:3072
    ds_read_b128 v[116:119], v4 offset:4096
    ds_read_b64 v[108:109], v4 offset:5120
    ds_read_b32 v127, v2 offset:45324
    v_cndmask_b32 v3, 2.0, v1, s[42:43]
    s_waitcnt lgkmcnt(7)
    v_xor_b32 v28, v120, v28
    v_xor_b32 v29, v121, v29
    v_xor_b32 v30, v122, v30
    v_xor_b32 v31, v123, v31
    buffer_store_dwordx4 v[28:31], v3, s[8:11], s73 offen sc1
    s_and_b32 s44, s2, 0xf0
    s_and_b32 s76, s2, 7
    s_lshl_b32 s76, s76, 1
    s_or_b32 s44, s44, s76
    s_bfe_u32 s76, s2, 0x10003
    s_or_b32 s44, s44, s76
    s_lshl_b32 s44, s44, 6
    s_mul_i32 s76, s3, 266240
    s_add_u32 s44, s44, s76
    s_add_u32 s45, s44, 6291456
    s_add_u32 s44, s44, 4096
    s_lshl_b32 s50, s3, 13
    s_add_u32 s50, s50, 8448

    s_waitcnt vmcnt(2) lgkmcnt(0)
    v_xor_b32 v124, 32, v21
    v_xor_b32 v125, 64, v21
    v_xor_b32 v126, 96, v21
    s_barrier
    s_cmp_ge_u32 s3, 8
    s_cbranch_scc1 L_noq
    s_add_u32 s81, s50, 65536
    v_add_u32 v108, s81, v108
    v_xor_b32 v4, 32, v108
    ds_read_b64 v[96:97], v108
    v_xor_b32 v5, 64, v108
    ds_read_b64 v[98:99], v4
    v_xor_b32 v4, 0x60, v108
    ds_read_b64 v[112:113], v5
    v_mov_b32 v6, 76032
    ds_read_b64 v[114:115], v4
    v_add_u32 v7, v6, v21
    ds_read_b64_tr_b16 v[64:65], v7 offset:0
    ds_read_b64_tr_b16 v[66:67], v7 offset:2048
    ds_read_b64_tr_b16 v[68:69], v7 offset:8192
    ds_read_b64_tr_b16 v[70:71], v7 offset:10240
    v_add_u32 v7, v6, v124
    ds_read_b64_tr_b16 v[72:73], v7 offset:0
    ds_read_b64_tr_b16 v[74:75], v7 offset:2048
    ds_read_b64_tr_b16 v[76:77], v7 offset:8192
    ds_read_b64_tr_b16 v[78:79], v7 offset:10240
    v_add_u32 v7, v6, v125
    ds_read_b64_tr_b16 v[80:81], v7 offset:0
    ds_read_b64_tr_b16 v[82:83], v7 offset:2048
    ds_read_b64_tr_b16 v[84:85], v7 offset:8192
    ds_read_b64_tr_b16 v[86:87], v7 offset:10240
    v_add_u32 v7, v6, v126
    ds_read_b64_tr_b16 v[88:89], v7 offset:0
    ds_read_b64_tr_b16 v[90:91], v7 offset:2048
    ds_read_b64_tr_b16 v[92:93], v7 offset:8192
    ds_read_b64_tr_b16 v[94:95], v7 offset:10240
    s_mul_i32 s76, s3, 144
    v_add_u32 v109, s76, v109
    s_mov_b32 s76, 0xbe38aa3b
    s_waitcnt lgkmcnt(12)
    v_mfma_f32_16x16x32_bf16 v[32:35], v[64:67], v[96:99], 0
    v_mfma_f32_16x16x32_bf16 v[32:35], v[68:71], v[112:115], v[32:35]
    s_waitcnt lgkmcnt(8)
    v_mfma_f32_16x16x32_bf16 v[36:39], v[72:75], v[96:99], 0
    v_mfma_f32_16x16x32_bf16 v[36:39], v[76:79], v[112:115], v[36:39]
    s_waitcnt lgkmcnt(4)
    v_mfma_f32_16x16x32_bf16 v[40:43], v[80:83], v[96:99], 0
    v_mfma_f32_16x16x32_bf16 v[40:43], v[84:87], v[112:115], v[40:43]
    s_waitcnt lgkmcnt(0)
    v_mfma_f32_16x16x32_bf16 v[44:47], v[88:91], v[96:99], 0
    v_mfma_f32_16x16x32_bf16 v[44:47], v[92:95], v[112:115], v[44:47]
    s_nop 1
    v_pk_mul_f32 v[32:33], v[32:33], s[76:77] op_sel_hi:[1,0]
    v_pk_mul_f32 v[34:35], v[34:35], s[76:77] op_sel_hi:[1,0]
    v_pk_mul_f32 v[36:37], v[36:37], s[76:77] op_sel_hi:[1,0]
    v_pk_mul_f32 v[38:39], v[38:39], s[76:77] op_sel_hi:[1,0]
    v_pk_mul_f32 v[40:41], v[40:41], s[76:77] op_sel_hi:[1,0]
    v_pk_mul_f32 v[42:43], v[42:43], s[76:77] op_sel_hi:[1,0]
    v_pk_mul_f32 v[44:45], v[44:45], s[76:77] op_sel_hi:[1,0]
    v_pk_mul_f32 v[46:47], v[46:47], s[76:77] op_sel_hi:[1,0]
    v_cvt_pk_bf16_f32 v64, v32, v33
    v_cvt_pk_bf16_f32 v65, v34, v35
    ds_write_b64 v109, v[64:65] offset:0
    v_cvt_pk_bf16_f32 v66, v36, v37
    v_cvt_pk_bf16_f32 v67, v38, v39
    ds_write_b64 v109, v[66:67] offset:32
    v_cvt_pk_bf16_f32 v68, v40, v41
    v_cvt_pk_bf16_f32 v69, v42, v43
    ds_write_b64 v109, v[68:69] offset:64
    v_cvt_pk_bf16_f32 v70, v44, v45
    v_cvt_pk_bf16_f32 v71, v46, v47
    ds_write_b64 v109, v[70:71] offset:96
L_noq:
    s_mul_i32 s54, s3, 1280
    s_add_u32 s54, s54, 139520
    s_and_b32 s76, s3, 7
    s_lshl_b32 s76, s76, 4
    s_add_u32 s76, s76, s50
    v_mov_b32 v4, s50
    v_mov_b32 v5, s54
    v_mov_b32 v48, 0
    v_mov_b32 v49, 0
    v_mov_b32 v50, 0
    v_mov_b32 v51, 0
    v_mov_b32 v52, 0
    v_mov_b32 v53, 0
    v_mov_b32 v54, 0
    v_mov_b32 v55, 0
    v_mov_b32 v56, 0
    v_mov_b32 v57, 0
    v_mov_b32 v58, 0
    v_mov_b32 v59, 0
    v_mov_b32 v60, 0
    v_mov_b32 v61, 0
    v_mov_b32 v62, 0
    v_mov_b32 v63, 0
    s_mov_b32 s14, 3200000
    s_mov_b32 s15, 0x20000
    s_lshl_b32 s51, s3, 15
    s_add_u32 s51, s51, s47
    s_sub_u32 s36, s4, 0
    s_subb_u32 s37, s5, 0
    s_or_b32 s37, s37, 0x800000
    s_movk_i32 s38, 25000
    s_mov_b32 s39, 0x20000
    s_sub_u32 s24, s4, 1024
    s_subb_u32 s25, s5, 0
    s_or_b32 s25, s25, 0x800000
    s_movk_i32 s26, 25000
    s_mov_b32 s27, 0x20000
    s_sub_u32 s28, s4, 2048
    s_subb_u32 s29, s5, 0
    s_or_b32 s29, s29, 0x800000
    s_movk_i32 s30, 25000
    s_mov_b32 s31, 0x20000
    s_sub_u32 s32, s4, 3072
    s_subb_u32 s33, s5, 0
    s_or_b32 s33, s33, 0x800000
    s_movk_i32 s34, 25000
    s_mov_b32 s35, 0x20000
    v_add_u32 v8, v4, v8
    v_add_u32 v9, v4, v9
    v_add_u32 v10, v4, v10
    v_add_u32 v11, v4, v11
    v_add_u32 v12, v4, v12
    v_add_u32 v13, v4, v13
    v_add_u32 v14, v5, v14
    v_add_u32 v15, v5, v15
    v_add_u32 v116, s76, v116
    v_add_u32 v117, s76, v117
    v_mov_b32 v101, v16
    v_mov_b32 v81, v16
    v_mov_b32 v103, v17
    v_mov_b32 v83, v17
    v_mov_b32 v105, v16
    v_mov_b32 v85, v16
    v_mov_b32 v107, v17
    v_mov_b32 v87, v17
    s_mov_b32 s48, 0xf80f8000
    s_mov_b32 s49, 0x7e07fff
    s_mov_b32 s52, 0
    s_mov_b32 s82, 0x88888888
    s_mov_b32 s83, s82
    s_mov_b32 s55, 0
    s_waitcnt vmcnt(0)
    buffer_load_dwordx4 v[24:27], v22, s[8:11], s44 offen sc1
L_poll:
    s_waitcnt vmcnt(0)
L_poll1:
    v_xor_b32 v24, v120, v24
    v_xor_b32 v25, v121, v25
    v_xor_b32 v26, v122, v26
    v_xor_b32 v27, v123, v27
    s_mov_b64 exec, -1
    v_or3_b32 v4, v24, v25, v26
    v_cmp_gt_u32 s[62:63], s49, v27
    v_bitop3_b32 v4, v4, v27, s48 bitop3:0xa8
    v_cmp_eq_u32 vcc, s49, v24
    v_cmp_ne_u32 s[56:57], 0, v4
    s_and_b64 s[42:43], s[62:63], s[82:83]
    s_lshr_b64 s[60:61], s[42:43], 1
    s_or_b64 s[42:43], s[42:43], s[60:61]
    s_lshr_b64 s[60:61], s[42:43], 2
    s_or_b64 s[42:43], s[42:43], s[60:61]
    s_cmp_lg_u64 s[56:57], 0
    s_cbranch_scc1 L_repoll
    s_cbranch_vccnz L_mark
L_marked:
    s_mov_b64 exec, s[42:43]
    s_cbranch_execz L_nosec
    buffer_load_dwordx4 v[28:31], v22, s[8:11], s45 offen sc1
L_nosec:
    s_mov_b64 exec, -1
    v_bfe_u32 v72, v24, 18, 6
    v_cmpx_gt_u32_e64 s[56:57], s49, v24
    ds_add_rtn_u32 v64, v72, v2 offset:8192
    s_mov_b64 exec, -1
    v_bfe_u32 v73, v25, 18, 6
    v_cmpx_gt_u32_e64 s[58:59], s49, v25
    ds_add_rtn_u32 v65, v73, v2 offset:8192
    s_mov_b64 exec, -1
    v_bfe_u32 v74, v26, 18, 6
    v_cmpx_gt_u32_e64 s[60:61], s49, v26
    ds_add_rtn_u32 v66, v74, v2 offset:8192
    s_mov_b64 exec, -1
    v_bfe_u32 v75, v27, 18, 6
    v_cmpx_gt_u32_e64 s[62:63], s49, v27
    ds_add_rtn_u32 v67, v75, v2 offset:8192
    s_mov_b64 exec, s[56:57]
    s_waitcnt lgkmcnt(3)
    ds_write_b32 v64, v24
    s_mov_b64 exec, s[58:59]
    s_waitcnt lgkmcnt(3)
    ds_write_b32 v65, v25
    s_mov_b64 exec, s[60:61]
    s_waitcnt lgkmcnt(3)
    ds_write_b32 v66, v26
    s_mov_b64 exec, s[62:63]
    s_waitcnt lgkmcnt(3)
    ds_write_b32 v67, v27
    s_mov_b64 exec, -1
    s_cmp_lt_u32 s3, 8
    s_cbranch_scc1 L_nowv
    v_and_b32 v6, 0x30, v0
    v_lshlrev_b32 v6, 1, v6
    v_xor_b32 v6, v6, v1
    s_lshl_b32 s76, s3, 10
    s_sub_u32 m0, s76, 8192
    s_sub_u32 s22, s22, 8192
    s_subb_u32 s23, s23, 0
    global_load_lds_dwordx4 v6, s[22:23]
L_nowv:
    s_cmp_ge_u32 s3, 2
    s_cbranch_scc1 L_nopf
    s_lshr_b32 s76, s2, 3
    s_mul_i32 s76, s76, 100352
    v_lshlrev_b32 v7, 7, v0
    buffer_load_dword v119, v7, s[4:7], s76 offen
L_nopf:
    s_mov_b32 m0, s50
    s_movk_i32 s76, 0x7fff
    s_mov_b32 s53, 0
    s_movk_i32 s77, 0
    s_cmp_ge_u32 s3, 8
    s_waitcnt lgkmcnt(0)
    s_barrier
    s_cbranch_scc1 L_noearly
L_try:
    ds_read_u16 v100, v14 offset:0
    ds_read_u16 v102, v14 offset:32
    ds_read_u16 v104, v14 offset:64
    ds_read_u16 v106, v14 offset:96
    ds_read_b128 v[96:99], v15
    s_waitcnt lgkmcnt(1)
    v_max3_u32 v4, v100, v102, v104
    v_max_u32 v4, v4, v106
    v_cmp_eq_u32 vcc, s76, v4
    s_cbranch_vccnz L_noearly
    s_setprio 3
    s_mov_b32 s53, 1
    buffer_load_dwordx4 v[100:101], s[36:39], 0 idxen offen offset:0 lds
    buffer_load_dwordx4 v[102:103], s[24:27], 0 idxen offen offset:1024 lds
    buffer_load_dwordx4 v[104:105], s[28:31], 0 idxen offen offset:2048 lds
    buffer_load_dwordx4 v[106:107], s[32:35], 0 idxen offen offset:3072 lds
    s_add_u32 m0, m0, 4096
    s_waitcnt lgkmcnt(0)
    v_perm_b32 v108, v19, v18, v96
    v_perm_b32 v109, v19, v18, v97
    v_perm_b32 v110, v19, v18, v98
    v_perm_b32 v111, v19, v18, v99
L_noearly:
    ds_read_b128 v[32:35], v116
    ds_read_b128 v[36:39], v116 offset:64
    ds_read_b128 v[40:43], v117
    ds_read_b128 v[44:47], v117 offset:64
    s_cmp_eq_u32 s53, 0
    s_cbranch_scc1 L_w0
    s_waitcnt vmcnt(5)
    s_cmp_lt_u32 s3, 2
    s_cbranch_scc1 L_sec
    s_waitcnt vmcnt(4)
    s_branch L_sec
L_w0:
    s_waitcnt vmcnt(0)
L_sec:
    s_mov_b64 exec, s[42:43]
    s_cbranch_execz L_secdone
L_poll2:
    v_xor_b32 v28, v120, v28
    v_xor_b32 v29, v121, v29
    v_xor_b32 v30, v122, v30
    v_xor_b32 v31, v123, v31
    s_mov_b64 exec, s[42:43]
    v_or3_b32 v4, v28, v29, v30
    v_bitop3_b32 v4, v4, v31, s48 bitop3:0xa8
    v_cmp_ne_u32 vcc, 0, v4
    s_cbranch_vccnz L_repoll2
L_pok2:
    v_bfe_u32 v72, v28, 18, 6
    v_cmpx_gt_u32_e64 s[56:57], s49, v28
    ds_add_rtn_u32 v64, v72, v2 offset:8192
    s_mov_b64 exec, s[42:43]
    v_bfe_u32 v73, v29, 18, 6
    v_cmpx_gt_u32_e64 s[58:59], s49, v29
    ds_add_rtn_u32 v65, v73, v2 offset:8192
    s_mov_b64 exec, s[42:43]
    v_bfe_u32 v74, v30, 18, 6
    v_cmpx_gt_u32_e64 s[60:61], s49, v30
    ds_add_rtn_u32 v66, v74, v2 offset:8192
    s_mov_b64 exec, s[42:43]
    v_bfe_u32 v75, v31, 18, 6
    v_cmpx_gt_u32_e64 s[62:63], s49, v31
    ds_add_rtn_u32 v67, v75, v2 offset:8192
    s_mov_b64 exec, s[56:57]
    s_waitcnt lgkmcnt(3)
    ds_write_b32 v64, v28
    s_mov_b64 exec, s[58:59]
    s_waitcnt lgkmcnt(3)
    ds_write_b32 v65, v29
    s_mov_b64 exec, s[60:61]
    s_waitcnt lgkmcnt(3)
    ds_write_b32 v66, v30
    s_mov_b64 exec, s[62:63]
    s_waitcnt lgkmcnt(3)
    ds_write_b32 v67, v31
    s_mov_b64 exec, -1
L_secdone:
    s_mov_b64 exec, -1
    s_cmp_lg_u32 s53, 0
    s_waitcnt lgkmcnt(0)
    s_barrier
    ds_read_b32 v4, v23 offset:8192
    s_cbranch_scc1 L_b4early
    s_setprio 3
    ds_read_u16 v100, v14 offset:0
    ds_read_u16 v102, v14 offset:32
    ds_read_u16 v104, v14 offset:64
    ds_read_u16 v106, v14 offset:96
    ds_read_u16 v80, v14 offset:128
    ds_read_u16 v82, v14 offset:160
    ds_read_u16 v84, v14 offset:192
    ds_read_u16 v86, v14 offset:224
    ds_read_b128 v[96:99], v15
    s_waitcnt lgkmcnt(9)
    v_cmp_gt_u32 vcc, v4, v118
    v_readlane_b32 s60, v4, s3
    s_cbranch_vccnz L_rare
L_goL:
    s_sub_u32 s60, s60, s54
    s_add_u32 s60, s60, 124
    s_bfe_u32 s61, s60, 0x20005
    s_lshr_b32 s60, s60, 7
    s_cmp_gt_u32 s60, 2
    s_cselect_b32 s61, s61, 3
    s_cmp_eq_u32 s60, 0
    s_waitcnt lgkmcnt(5)
    s_cbranch_scc1 L_loop_done
    buffer_load_dwordx4 v[100:101], s[36:39], 0 idxen offen offset:0 lds
    buffer_load_dwordx4 v[102:103], s[24:27], 0 idxen offen offset:1024 lds
    buffer_load_dwordx4 v[104:105], s[28:31], 0 idxen offen offset:2048 lds
    buffer_load_dwordx4 v[106:107], s[32:35], 0 idxen offen offset:3072 lds
    s_add_u32 m0, m0, 4096
    s_waitcnt lgkmcnt(0)
    ds_read_u16 v100, v14 offset:256
    ds_read_u16 v102, v14 offset:288
    ds_read_u16 v104, v14 offset:320
    ds_read_u16 v106, v14 offset:352
    v_perm_b32 v108, v19, v18, v96
    v_perm_b32 v109, v19, v18, v97
    v_perm_b32 v110, v19, v18, v98
    v_perm_b32 v111, v19, v18, v99
    s_branch L_second
L_b4early:
    ds_read_u16 v80, v14 offset:128
    ds_read_u16 v82, v14 offset:160
    ds_read_u16 v84, v14 offset:192
    ds_read_u16 v86, v14 offset:224
    ds_read_u16 v100, v14 offset:256
    ds_read_u16 v102, v14 offset:288
    ds_read_u16 v104, v14 offset:320
    ds_read_u16 v106, v14 offset:352
    s_waitcnt lgkmcnt(8)
    v_cmp_gt_u32 vcc, v4, v118
    v_readlane_b32 s60, v4, s3
    s_cbranch_vccnz L_rare
L_goE:
    s_sub_u32 s60, s60, s54
    s_add_u32 s60, s60, 124
    s_bfe_u32 s61, s60, 0x20005
    s_lshr_b32 s60, s60, 7
    s_cmp_gt_u32 s60, 2
    s_cselect_b32 s61, s61, 3
L_second:
    s_cmp_eq_u32 s60, 1
    s_waitcnt lgkmcnt(4)
    s_cbranch_scc1 L_loop
    buffer_load_dwordx4 v[80:81], s[36:39], 0 idxen offen offset:0 lds
    buffer_load_dwordx4 v[82:83], s[24:27], 0 idxen offen offset:1024 lds
    buffer_load_dwordx4 v[84:85], s[28:31], 0 idxen offen offset:2048 lds
    buffer_load_dwordx4 v[86:87], s[32:35], 0 idxen offen offset:3072 lds
L_loop:
    s_cmp_le_u32 s60, 2
    s_cbranch_scc1 L_tailwait0
    s_waitcnt vmcnt(4)
L_comp0:
    ds_read_b128 v[64:67], v8 offset:0
    ds_read_b128 v[68:71], v9 offset:0
    ds_read_b128 v[72:75], v8 offset:512
    ds_read_b128 v[76:79], v9 offset:512
    ds_read_b128 v[96:99], v15 offset:128
    ds_read_b64_tr_b16 v[80:81], v10 offset:0
    ds_read_b64_tr_b16 v[82:83], v10 offset:512
    ds_read_b64_tr_b16 v[84:85], v11 offset:0
    ds_read_b64_tr_b16 v[86:87], v11 offset:512
    ds_read_b64_tr_b16 v[88:89], v12 offset:0
    ds_read_b64_tr_b16 v[90:91], v12 offset:512
    ds_read_b64_tr_b16 v[92:93], v13 offset:0
    ds_read_b64_tr_b16 v[94:95], v13 offset:512
    s_waitcnt lgkmcnt(11)
    v_mfma_f32_16x16x32_bf16 v[108:111], v[64:67], v[32:35], v[108:111]
    v_mfma_f32_16x16x32_bf16 v[108:111], v[68:71], v[36:39], v[108:111]
    s_waitcnt lgkmcnt(9)
    v_mfma_f32_16x16x32_bf16 v[108:111], v[72:75], v[40:43], v[108:111]
    v_mfma_f32_16x16x32_bf16 v[108:111], v[76:79], v[44:47], v[108:111]
    s_xor_b32 m0, m0, 0x1000
    s_nop 6
    v_exp_f32 v108, v108
    v_exp_f32 v109, v109
    v_exp_f32 v110, v110
    v_exp_f32 v111, v111
    v_pk_add_f32 v[108:109], v[108:109], 1.0 op_sel_hi:[1,0]
    v_pk_add_f32 v[110:111], v[110:111], 1.0 op_sel_hi:[1,0]
    v_rcp_f32 v108, v108
    v_rcp_f32 v109, v109
    v_rcp_f32 v110, v110
    v_rcp_f32 v111, v111
    s_waitcnt lgkmcnt(0)
    v_cvt_pk_bf16_f32 v112, v108, v109
    v_cvt_pk_bf16_f32 v113, v110, v111
    v_perm_b32 v108, v19, v18, v96
    v_mov_b32_dpp v114, v112 row_ror:8 row_mask:0xf bank_mask:0xf
    v_mov_b32_dpp v115, v113 row_ror:8 row_mask:0xf bank_mask:0xf
    v_perm_b32 v109, v19, v18, v97
    v_perm_b32 v110, v19, v18, v98
    v_mfma_f32_16x16x32_bf16 v[48:51], v[80:83], v[112:115], v[48:51]
    v_mfma_f32_16x16x32_bf16 v[52:55], v[84:87], v[112:115], v[52:55]
    v_mfma_f32_16x16x32_bf16 v[56:59], v[88:91], v[112:115], v[56:59]
    v_mfma_f32_16x16x32_bf16 v[60:63], v[92:95], v[112:115], v[60:63]
    v_perm_b32 v111, v19, v18, v99
    s_cmp_le_u32 s60, 3
    s_cbranch_scc1 L_tailissue0
    buffer_load_dwordx4 v[100:101], s[36:39], 0 idxen offen offset:0 lds
    buffer_load_dwordx4 v[102:103], s[24:27], 0 idxen offen offset:1024 lds
    buffer_load_dwordx4 v[104:105], s[28:31], 0 idxen offen offset:2048 lds
    buffer_load_dwordx4 v[106:107], s[32:35], 0 idxen offen offset:3072 lds
    ds_read_u16 v100, v14 offset:384
    ds_read_u16 v102, v14 offset:416
    ds_read_u16 v104, v14 offset:448
    ds_read_u16 v106, v14 offset:480
L_noissue0:
    s_sub_u32 s60, s60, 1
    s_bitcmp1_b32 0x2b, s60
    s_cbranch_scc1 L_prio0
L_prioback0:
    s_cmp_le_u32 s60, 2
    s_cbranch_scc1 L_tailwait1
    s_waitcnt vmcnt(4)
L_comp1:
    ds_read_b128 v[64:67], v8 offset:4096
    ds_read_b128 v[68:71], v9 offset:4096
    ds_read_b128 v[72:75], v8 offset:4608
    ds_read_b128 v[76:79], v9 offset:4608
    ds_read_b128 v[96:99], v15 offset:256
    ds_read_b64_tr_b16 v[80:81], v10 offset:4096
    ds_read_b64_tr_b16 v[82:83], v10 offset:4608
    ds_read_b64_tr_b16 v[84:85], v11 offset:4096
    ds_read_b64_tr_b16 v[86:87], v11 offset:4608
    ds_read_b64_tr_b16 v[88:89], v12 offset:4096
    ds_read_b64_tr_b16 v[90:91], v12 offset:4608
    ds_read_b64_tr_b16 v[92:93], v13 offset:4096
    ds_read_b64_tr_b16 v[94:95], v13 offset:4608
    s_waitcnt lgkmcnt(11)
    v_mfma_f32_16x16x32_bf16 v[108:111], v[64:67], v[32:35], v[108:111]
    v_mfma_f32_16x16x32_bf16 v[108:111], v[68:71], v[36:39], v[108:111]
    s_waitcnt lgkmcnt(9)
    v_mfma_f32_16x16x32_bf16 v[108:111], v[72:75], v[40:43], v[108:111]
    v_mfma_f32_16x16x32_bf16 v[108:111], v[76:79], v[44:47], v[108:111]
    s_xor_b32 m0, m0, 0x1000
    s_nop 6
    v_exp_f32 v108, v108
    v_exp_f32 v109, v109
    v_exp_f32 v110, v110
    v_exp_f32 v111, v111
    v_pk_add_f32 v[108:109], v[108:109], 1.0 op_sel_hi:[1,0]
    v_pk_add_f32 v[110:111], v[110:111], 1.0 op_sel_hi:[1,0]
    v_rcp_f32 v108, v108
    v_rcp_f32 v109, v109
    v_rcp_f32 v110, v110
    v_rcp_f32 v111, v111
    s_waitcnt lgkmcnt(0)
    v_cvt_pk_bf16_f32 v112, v108, v109
    v_cvt_pk_bf16_f32 v113, v110, v111
    v_perm_b32 v108, v19, v18, v96
    v_mov_b32_dpp v114, v112 row_ror:8 row_mask:0xf bank_mask:0xf
    v_mov_b32_dpp v115, v113 row_ror:8 row_mask:0xf bank_mask:0xf
    v_perm_b32 v109, v19, v18, v97
    v_perm_b32 v110, v19, v18, v98
    v_mfma_f32_16x16x32_bf16 v[48:51], v[80:83], v[112:115], v[48:51]
    v_mfma_f32_16x16x32_bf16 v[52:55], v[84:87], v[112:115], v[52:55]
    v_mfma_f32_16x16x32_bf16 v[56:59], v[88:91], v[112:115], v[56:59]
    v_mfma_f32_16x16x32_bf16 v[60:63], v[92:95], v[112:115], v[60:63]
    v_perm_b32 v111, v19, v18, v99
    s_cmp_le_u32 s60, 3
    s_cbranch_scc1 L_tailissue1
    buffer_load_dwordx4 v[100:101], s[36:39], 0 idxen offen offset:0 lds
    buffer_load_dwordx4 v[102:103], s[24:27], 0 idxen offen offset:1024 lds
    buffer_load_dwordx4 v[104:105], s[28:31], 0 idxen offen offset:2048 lds
    buffer_load_dwordx4 v[106:107], s[32:35], 0 idxen offen offset:3072 lds
    ds_read_u16 v100, v14 offset:512
    ds_read_u16 v102, v14 offset:544
    ds_read_u16 v104, v14 offset:576
    ds_read_u16 v106, v14 offset:608
L_noissue1:
    v_add_u32 v14, 256, v14
    v_add_u32 v15, 256, v15
    s_sub_u32 s60, s60, 1
    s_bitcmp1_b32 0x2b, s60
    s_cbranch_scc1 L_prio1
L_prioback1:
    s_branch L_loop
L_loop_done:
    s_waitcnt lgkmcnt(0)
    s_cmp_lg_u32 s55, 0
    s_cbranch_scc1 L_extra
    ds_read_b64_tr_b16 v[64:65], v21 offset:0
    ds_read_b64_tr_b16 v[66:67], v21 offset:2048
    ds_read_b64_tr_b16 v[68:69], v21 offset:4096
    ds_read_b64_tr_b16 v[70:71], v21 offset:6144
    ds_read_b64_tr_b16 v[72:73], v124 offset:0
    ds_read_b64_tr_b16 v[74:75], v124 offset:2048
    ds_read_b64_tr_b16 v[76:77], v124 offset:4096
    ds_read_b64_tr_b16 v[78:79], v124 offset:6144
    ds_read_b64_tr_b16 v[80:81], v125 offset:0
    ds_read_b64_tr_b16 v[82:83], v125 offset:2048
    ds_read_b64_tr_b16 v[84:85], v125 offset:4096
    ds_read_b64_tr_b16 v[86:87], v125 offset:6144
    ds_read_b64_tr_b16 v[88:89], v126 offset:0
    ds_read_b64_tr_b16 v[90:91], v126 offset:2048
    ds_read_b64_tr_b16 v[92:93], v126 offset:4096
    ds_read_b64_tr_b16 v[94:95], v126 offset:6144
    v_cvt_pk_bf16_f32 v32, v48, v49
    v_cvt_pk_bf16_f32 v33, v50, v51
    v_cvt_pk_bf16_f32 v34, v52, v53
    v_cvt_pk_bf16_f32 v35, v54, v55
    v_cvt_pk_bf16_f32 v36, v56, v57
    v_cvt_pk_bf16_f32 v37, v58, v59
    v_cvt_pk_bf16_f32 v38, v60, v61
    v_cvt_pk_bf16_f32 v39, v62, v63
    s_nop 0
    s_waitcnt lgkmcnt(12)
    v_mfma_f32_16x16x32_bf16 v[48:51], v[64:67], v[32:35], 0
    v_mfma_f32_16x16x32_bf16 v[48:51], v[68:71], v[36:39], v[48:51]
    s_waitcnt lgkmcnt(8)
    v_mfma_f32_16x16x32_bf16 v[52:55], v[72:75], v[32:35], 0
    v_mfma_f32_16x16x32_bf16 v[52:55], v[76:79], v[36:39], v[52:55]
    s_waitcnt lgkmcnt(4)
    v_mfma_f32_16x16x32_bf16 v[56:59], v[80:83], v[32:35], 0
    v_mfma_f32_16x16x32_bf16 v[56:59], v[84:87], v[36:39], v[56:59]
    s_waitcnt lgkmcnt(0)
    v_mfma_f32_16x16x32_bf16 v[60:63], v[88:91], v[32:35], 0
    v_mfma_f32_16x16x32_bf16 v[60:63], v[92:95], v[36:39], v[60:63]
    v_cvt_pk_bf16_f32 v40, v48, v49
    v_cvt_pk_bf16_f32 v41, v50, v51
    v_cvt_pk_bf16_f32 v42, v52, v53
    v_cvt_pk_bf16_f32 v43, v54, v55
    s_nop 1
    v_permlane16_swap_b32 v40, v42
    v_permlane16_swap_b32 v41, v43
    v_cvt_pk_bf16_f32 v44, v56, v57
    v_cvt_pk_bf16_f32 v45, v58, v59
    v_cvt_pk_bf16_f32 v46, v60, v61
    v_cvt_pk_bf16_f32 v47, v62, v63
    buffer_store_dwordx4 v[40:43], v20, s[12:15], s51 offen sc1 nt
    s_nop 0
    v_permlane16_swap_b32 v44, v46
    v_permlane16_swap_b32 v45, v47
    buffer_store_dwordx4 v[44:47], v20, s[12:15], s51 offen offset:64 sc1 nt
    s_or_b32 s77, s2, s3
    s_cbranch_scc1 L_fin
    v_mov_b32 v5, 0
    s_mov_b64 exec, 1
    buffer_store_dword v127, v5, s[8:11], 0 offen sc1
    s_mov_b64 exec, -1
L_fin:
L_done:
    s_endpgm

L_prio0:
    s_cmp_eq_u32 s60, 0
    s_cbranch_scc1 L_loop_done
    s_setprio 0
    s_cmp_eq_u32 s60, 1
    s_cbranch_scc1 L_prioback0
    s_setprio 1
    s_cmp_eq_u32 s60, 3
    s_cbranch_scc1 L_prioback0
    s_setprio 2
    s_branch L_prioback0
L_prio1:
    s_cmp_eq_u32 s60, 0
    s_cbranch_scc1 L_loop_done
    s_setprio 0
    s_cmp_eq_u32 s60, 1
    s_cbranch_scc1 L_prioback1
    s_setprio 1
    s_cmp_eq_u32 s60, 3
    s_cbranch_scc1 L_prioback1
    s_setprio 2
    s_branch L_prioback1
L_tailwait0:
    s_cmp_eq_u32 s60, 1
    s_cbranch_scc1 L_tw0_0
    s_waitcnt vmcnt(4)
    s_cmp_eq_u32 s61, 3
    s_cbranch_scc1 L_comp0
    s_waitcnt vmcnt(3)
    s_cmp_eq_u32 s61, 2
    s_cbranch_scc1 L_comp0
    s_waitcnt vmcnt(2)
    s_cmp_eq_u32 s61, 1
    s_cbranch_scc1 L_comp0
    s_waitcnt vmcnt(1)
    s_branch L_comp0
L_tw0_0:
    s_waitcnt vmcnt(0)
    s_branch L_comp0
L_tailissue0:
    s_cmp_lg_u32 s60, 3
    s_cbranch_scc1 L_noissue0
    buffer_load_dwordx4 v[100:101], s[36:39], 0 idxen offen offset:0 lds
    s_cmp_eq_u32 s61, 0
    s_cbranch_scc1 L_noissue0
    buffer_load_dwordx4 v[102:103], s[24:27], 0 idxen offen offset:1024 lds
    s_cmp_eq_u32 s61, 1
    s_cbranch_scc1 L_noissue0
    buffer_load_dwordx4 v[104:105], s[28:31], 0 idxen offen offset:2048 lds
    s_cmp_eq_u32 s61, 2
    s_cbranch_scc1 L_noissue0
    buffer_load_dwordx4 v[106:107], s[32:35], 0 idxen offen offset:3072 lds
    s_branch L_noissue0
L_tailwait1:
    s_cmp_eq_u32 s60, 1
    s_cbranch_scc1 L_tw0_1
    s_waitcnt vmcnt(4)
    s_cmp_eq_u32 s61, 3
    s_cbranch_scc1 L_comp1
    s_waitcnt vmcnt(3)
    s_cmp_eq_u32 s61, 2
    s_cbranch_scc1 L_comp1
    s_waitcnt vmcnt(2)
    s_cmp_eq_u32 s61, 1
    s_cbranch_scc1 L_comp1
    s_waitcnt vmcnt(1)
    s_branch L_comp1
L_tw0_1:
    s_waitcnt vmcnt(0)
    s_branch L_comp1
L_tailissue1:
    s_cmp_lg_u32 s60, 3
    s_cbranch_scc1 L_noissue1
    buffer_load_dwordx4 v[100:101], s[36:39], 0 idxen offen offset:0 lds
    s_cmp_eq_u32 s61, 0
    s_cbranch_scc1 L_noissue1
    buffer_load_dwordx4 v[102:103], s[24:27], 0 idxen offen offset:1024 lds
    s_cmp_eq_u32 s61, 1
    s_cbranch_scc1 L_noissue1
    buffer_load_dwordx4 v[104:105], s[28:31], 0 idxen offen offset:2048 lds
    s_cmp_eq_u32 s61, 2
    s_cbranch_scc1 L_noissue1
    buffer_load_dwordx4 v[106:107], s[32:35], 0 idxen offen offset:3072 lds
    s_branch L_noissue1
L_retry:
    s_sub_u32 s77, s77, 1
    s_cmp_lg_u32 s77, 0
    s_cbranch_scc1 L_try
    s_branch L_noearly
L_repoll:
    s_add_u32 s52, s52, 1
    s_mov_b32 s76, 4000
    s_cmp_eq_u32 s2, 0
    s_cselect_b32 s76, 200000, s76
    s_cmp_ge_u32 s52, s76
    s_cbranch_scc1 L_timeout
    s_mov_b64 exec, s[56:57]
    buffer_load_dwordx4 v[24:27], v22, s[8:11], s44 offen sc1
    s_branch L_poll
L_table:
    v_and_b32 v96, 63, v0
    v_and_b32 v4, s80, v1
    v_add_u32 v4, 65792, v4
    s_cmp_eq_u32 s3, 14
    s_cbranch_scc1 L_table14
    s_cmp_eq_u32 s3, 15
    s_cbranch_scc1 L_table15
    v_and_b32 v6, 0x30, v0
    v_bitop3_b32 v113, v1, v6, s78 bitop3:0x28
    v_bfe_u32 v7, v0, 3, 3
    v_lshl_or_b32 v113, v7, 15, v113
    v_xor_b32 v114, 64, v113
    s_waitcnt lgkmcnt(0)
    s_mov_b32 m0, 73984
    s_add_u32 s76, s47, 0
    buffer_load_dwordx4 v113, s[4:7], s76 offen lds
    s_mov_b32 m0, 75008
    s_add_u32 s76, s47, 262144
    buffer_load_dwordx4 v114, s[4:7], s76 offen lds
    s_mov_b32 m0, 82176
    s_add_u32 s76, s47, 524288
    buffer_load_dwordx4 v113, s[4:7], s76 offen lds
    s_mov_b32 m0, 83200
    s_add_u32 s76, s47, 786432
    buffer_load_dwordx4 v114, s[4:7], s76 offen lds
    s_mov_b32 m0, 90368
    s_add_u32 s76, s47, 1048576
    buffer_load_dwordx4 v113, s[4:7], s76 offen lds
    s_mov_b32 m0, 91392
    s_add_u32 s76, s47, 1310720
    buffer_load_dwordx4 v114, s[4:7], s76 offen lds
    s_mov_b32 m0, 98560
    s_add_u32 s76, s47, 1572864
    buffer_load_dwordx4 v113, s[4:7], s76 offen lds
    s_mov_b32 m0, 99584
    s_add_u32 s76, s47, 1835008
    buffer_load_dwordx4 v114, s[4:7], s76 offen lds
    s_mov_b32 m0, 106752
    s_add_u32 s76, s47, 2097152
    buffer_load_dwordx4 v113, s[4:7], s76 offen lds
    s_mov_b32 m0, 107776
    s_add_u32 s76, s47, 2359296
    buffer_load_dwordx4 v114, s[4:7], s76 offen lds
    s_mov_b32 m0, 114944
    s_add_u32 s76, s47, 2621440
    buffer_load_dwordx4 v113, s[4:7], s76 offen lds
    s_mov_b32 m0, 115968
    s_add_u32 s76, s47, 2883584
    buffer_load_dwordx4 v114, s[4:7], s76 offen lds
    v_and_b32 v97, 3, v96
    v_bfe_u32 v98, v96, 2, 2
    v_lshl_add_u32 v24, v98, 3, v97
    v_lshlrev_b32 v24, 7, v24
    v_lshrrev_b32 v99, 4, v96
    v_and_b32 v25, 6, v96
    v_xor_b32 v25, v25, v99
    v_lshl_or_b32 v24, v25, 4, v24
    v_xor_b32 v25, 64, v24
    v_lshl_add_u32 v26, v99, 3, v98
    v_lshlrev_b32 v26, 7, v26
    v_bfe_u32 v98, v96, 3, 2
    v_lshl_or_b32 v26, v98, 5, v26
    v_lshl_or_b32 v26, v97, 3, v26
    v_xor_b32 v27, 32, v26
    v_xor_b32 v28, 64, v26
    v_xor_b32 v29, 0x60, v26
    v_lshrrev_b32 v30, 3, v96
    v_lshlrev_b32 v31, 4, v30
    v_lshlrev_b32 v30, 2, v30
    ds_write_b128 v4, v[24:27]
    ds_write_b128 v4, v[28:31] offset:1024
    s_branch L_p1skip
L_table14:
    v_and_b32 v6, 0x30, v0
    v_bitop3_b32 v113, v1, v6, s78 bitop3:0x28
    v_bfe_u32 v7, v0, 3, 3
    v_lshl_or_b32 v113, v7, 15, v113
    v_xor_b32 v114, 64, v113
    s_waitcnt lgkmcnt(0)
    v_lshlrev_b32 v6, 1, v6
    v_bitop3_b32 v112, v1, v6, s80 bitop3:0x28
    s_mov_b32 m0, 76032
    s_nop 0
    global_load_lds_dwordx4 v112, s[20:21] offset:0
    global_load_lds_dwordx4 v112, s[20:21] offset:1024
    global_load_lds_dwordx4 v112, s[20:21] offset:2048
    global_load_lds_dwordx4 v112, s[20:21] offset:3072
    s_mov_b32 m0, 84224
    v_add_u32 v112, 0x1000, v112
    global_load_lds_dwordx4 v112, s[20:21] offset:0
    global_load_lds_dwordx4 v112, s[20:21] offset:1024
    global_load_lds_dwordx4 v112, s[20:21] offset:2048
    global_load_lds_dwordx4 v112, s[20:21] offset:3072
    s_mov_b32 m0, 123136
    s_add_u32 s76, s47, 3145728
    buffer_load_dwordx4 v113, s[4:7], s76 offen lds
    s_mov_b32 m0, 124160
    s_add_u32 s76, s47, 3407872
    buffer_load_dwordx4 v114, s[4:7], s76 offen lds
    s_mov_b32 m0, 131328
    s_add_u32 s76, s47, 3670016
    buffer_load_dwordx4 v113, s[4:7], s76 offen lds
    s_mov_b32 m0, 132352
    s_add_u32 s76, s47, 3932160
    buffer_load_dwordx4 v114, s[4:7], s76 offen lds
    v_and_b32 v97, 7, v96
    v_and_b32 v98, 16, v96
    v_lshlrev_b32 v24, 4, v97
    v_lshlrev_b32 v98, 1, v98
    v_xor_b32 v24, v24, v98
    v_xor_b32 v25, 64, v24
    v_lshlrev_b32 v99, 3, v97
    v_mov_b32 v26, 0x5f
    v_mov_b32 v27, 0
    v_lshlrev_b64 v[26:27], v99, v[26:27]
    v_xor_b32 v26, 0x5f5f5f5f, v26
    v_xor_b32 v27, 0x5f5f5f5f, v27
    v_and_b32 v99, 15, v96
    v_lshl_or_b32 v28, v99, 19, v98
    v_lshrrev_b32 v99, 5, v96
    v_lshl_or_b32 v28, v99, 4, v28
    v_lshrrev_b32 v98, 2, v96
    v_lshlrev_b32 v29, 7, v98
    v_bfe_u32 v97, v96, 3, 2
    v_lshl_or_b32 v29, v97, 5, v29
    v_and_b32 v97, 3, v96
    v_lshl_or_b32 v29, v97, 3, v29
    v_mul_u32_u24 v30, 16640, v98
    v_lshl_add_u32 v30, v97, 4, v30
    v_lshlrev_b32 v31, 2, v96
    ds_write_b128 v4, v[24:27] offset:2048
    ds_write_b128 v4, v[28:31] offset:3072
    s_branch L_p1skip
L_table15:
    v_and_b32 v97, 7, v96
    v_and_b32 v98, 8, v96
    v_cmp_eq_u32 vcc, 0, v98
    v_lshrrev_b32 v99, 4, v96
    v_lshlrev_b32 v28, 4, v99
    v_add_u32 v29, 6912, v28
    v_cndmask_b32 v24, 7, v97, vcc
    v_mov_b32 v25, 7
    v_cndmask_b32 v25, v97, v25, vcc
    s_movk_i32 s76, 144
    v_mad_u32_u24 v24, v24, s76, v29
    v_mad_u32_u24 v25, v25, s76, v29
    v_mul_u32_u24 v26, 1280, v96
    v_add_u32 v26, 140800, v26
    v_cmp_gt_u32 vcc, 16, v96
    v_mov_b32 v27, 0
    v_and_b32 v98, 15, v96
    v_cndmask_b32 v26, 0, v26, vcc
    v_lshlrev_b32 v28, 7, v98
    v_lshl_or_b32 v28, v99, 3, v28
    v_and_b32 v29, 14, v96
    v_lshlrev_b32 v29, 3, v29
    v_xor_b32 v28, v28, v29
    v_lshlrev_b32 v29, 13, v98
    v_lshl_add_u32 v29, v97, 4, v29
    v_lshl_add_u32 v29, v99, 3, v29
    v_add_u32 v29, 15360, v29
    ds_write_b128 v4, v[24:27] offset:4096
    ds_write_b64 v4, v[28:29] offset:5120
    s_waitcnt lgkmcnt(0)
    s_mov_b32 s41, s40
    s_lshr_b64 s[76:77], s[40:41], 15
    s_add_u32 s76, s76, 1
    s_mov_b32 s77, s76
    s_mov_b32 s48, 0xf80f8000
    s_lshr_b64 s[40:41], s[76:77], 17
    s_lshr_b64 s[56:57], s[76:77], 25
    s_lshr_b64 s[58:59], s[76:77], 1
    s_lshr_b64 s[60:61], s[76:77], 9
    s_and_b32 s41, s40, s48
    s_and_b32 s56, s56, s48
    s_and_b32 s58, s58, s48
    s_and_b32 s60, s60, s48
    v_mov_b32 v24, s41
    v_mov_b32 v25, s56
    v_mov_b32 v26, s58
    v_mov_b32 v27, s60
    v_mov_b32 v28, s40
    ds_write_b128 v2, v[24:27] offset:45308
    ds_write_b32 v2, v28 offset:45324
    s_branch L_p1skip

L_slotfull:
    v_mov_b32 v5, 0x7e07fff
    v_cndmask_b32 v80, v80, v5, vcc
    v_cndmask_b32 v81, v81, v5, vcc
    v_cndmask_b32 v82, v82, v5, vcc
    v_cndmask_b32 v83, v83, v5, vcc
    s_branch L_slotok
L_repoll2:
    s_add_u32 s52, s52, 1
    s_mov_b64 exec, vcc
    s_cmp_ge_u32 s52, 400000
    s_cbranch_scc1 L_giveup2
    buffer_load_dwordx4 v[28:31], v22, s[8:11], s45 offen sc1
    s_waitcnt vmcnt(0)
    s_branch L_poll2
L_giveup2:
    s_andn2_b64 s[42:43], s[42:43], vcc
    s_mov_b64 exec, s[42:43]
    s_branch L_pok2
L_timeout:
    s_mov_b32 s76, 0x11111111
    s_mov_b32 s77, s76
    s_lshr_b64 s[58:59], s[56:57], 1
    s_or_b64 s[56:57], s[56:57], s[58:59]
    s_lshr_b64 s[58:59], s[56:57], 2
    s_or_b64 s[56:57], s[56:57], s[58:59]
    s_and_b64 s[56:57], s[56:57], s[76:77]
    s_lshl_b64 s[58:59], s[56:57], 1
    s_or_b64 s[56:57], s[56:57], s[58:59]
    s_lshl_b64 s[58:59], s[56:57], 2
    s_or_b64 s[56:57], s[56:57], s[58:59]
    s_andn2_b64 s[42:43], s[42:43], s[56:57]
    s_or_b64 vcc, vcc, s[56:57]
    s_mov_b64 exec, s[56:57]
    v_mov_b32 v24, s49
    v_mov_b32 v25, s49
    v_mov_b32 v26, s49
    v_mov_b32 v27, s49
    s_mov_b64 exec, -1
L_mark:
    v_lshrrev_b32 v4, 2, v0
    v_and_b32 v5, 31, v4
    v_lshlrev_b32 v5, v5, 1
    v_lshrrev_b32 v4, 5, v4
    v_lshlrev_b32 v4, 2, v4
    s_mov_b64 exec, vcc
    ds_or_b32 v4, v5 offset:8320
    s_mov_b64 exec, -1
    s_branch L_marked
L_rare:
    s_cmp_lg_u32 vcc_hi, 0
    s_cselect_b32 s55, 2, 0
    s_and_b32 s76, vcc_lo, 0xffff
    s_cbranch_scc1 L_rebin
    s_cmp_lg_u32 s53, 0
    s_cbranch_scc1 L_goE
    s_branch L_goL
L_rebin:
    s_or_b32 s55, s55, 1
    s_not_b64 exec, s[42:43]
    v_mov_b32 v28, s49
    v_mov_b32 v29, s49
    v_mov_b32 v30, s49
    v_mov_b32 v31, s49
    s_mov_b64 exec, -1
L_extra:
    v_mov_b32 v4, 0
    ds_read_b128 v[64:67], v4 offset:8320
    ds_read_b128 v[68:71], v4 offset:8336
    s_waitcnt lgkmcnt(0)
    s_barrier
    s_mov_b32 s56, -1
    s_and_b32 s61, s55, 2
    s_and_b32 s76, s55, 1
    s_cbranch_scc1 L_reinit
    s_mov_b32 s57, 0
    v_readfirstlane_b32 s76, v71
    s_bcnt1_i32_b32 s77, s76
    s_add_u32 s57, s57, s77
    s_ff1_i32_b32 s77, s76
    s_add_u32 s77, s77, 224
    s_cmp_lg_u32 s76, 0
    s_cselect_b32 s56, s77, s56
    v_readfirstlane_b32 s76, v70
    s_bcnt1_i32_b32 s77, s76
    s_add_u32 s57, s57, s77
    s_ff1_i32_b32 s77, s76
    s_add_u32 s77, s77, 192
    s_cmp_lg_u32 s76, 0
    s_cselect_b32 s56, s77, s56
    v_readfirstlane_b32 s76, v69
    s_bcnt1_i32_b32 s77, s76
    s_add_u32 s57, s57, s77
    s_ff1_i32_b32 s77, s76
    s_add_u32 s77, s77, 160
    s_cmp_lg_u32 s76, 0
    s_cselect_b32 s56, s77, s56
    v_readfirstlane_b32 s76, v68
    s_bcnt1_i32_b32 s77, s76
    s_add_u32 s57, s57, s77
    s_ff1_i32_b32 s77, s76
    s_add_u32 s77, s77, 128
    s_cmp_lg_u32 s76, 0
    s_cselect_b32 s56, s77, s56
    v_readfirstlane_b32 s76, v67
    s_bcnt1_i32_b32 s77, s76
    s_add_u32 s57, s57, s77
    s_ff1_i32_b32 s77, s76
    s_add_u32 s77, s77, 96
    s_cmp_lg_u32 s76, 0
    s_cselect_b32 s56, s77, s56
    v_readfirstlane_b32 s76, v66
    s_bcnt1_i32_b32 s77, s76
    s_add_u32 s57, s57, s77
    s_ff1_i32_b32 s77, s76
    s_add_u32 s77, s77, 64
    s_cmp_lg_u32 s76, 0
    s_cselect_b32 s56, s77, s56
    v_readfirstlane_b32 s76, v65
    s_bcnt1_i32_b32 s77, s76
    s_add_u32 s57, s57, s77
    s_ff1_i32_b32 s77, s76
    s_add_u32 s77, s77, 32
    s_cmp_lg_u32 s76, 0
    s_cselect_b32 s56, s77, s56
    v_readfirstlane_b32 s76, v64
    s_bcnt1_i32_b32 s77, s76
    s_add_u32 s57, s57, s77
    s_ff1_i32_b32 s77, s76
    s_add_u32 s77, s77, 0
    s_cmp_lg_u32 s76, 0
    s_cselect_b32 s56, s77, s56
    s_cmp_gt_u32 s57, 1
    s_cselect_b32 s61, 2, 0
    s_and_b32 s56, s56, 0xff
    s_mul_i32 s76, s56, 12544
    v_add_u32 v4, s76, v1
    s_movk_i32 s77, 784
    s_cmp_eq_u32 s56, 255
    s_cselect_b32 s77, 80, s77
    v_cmp_gt_u32 s[74:75], s77, v0
    v_mov_b32 v24, s49
    v_mov_b32 v25, s49
    v_mov_b32 v26, s49
    v_mov_b32 v27, s49
    v_mov_b32 v28, s49
    v_mov_b32 v29, s49
    v_mov_b32 v30, s49
    v_mov_b32 v31, s49
    s_mov_b64 exec, s[74:75]
    s_cbranch_execz L_rs_done
    global_load_dwordx4 v[80:83], v4, s[18:19]
    global_load_dwordx4 v[84:87], v4, s[16:17]
    s_waitcnt vmcnt(0)
    v_and_b32 v4, 0xff, v80
    v_cmp_eq_u32 vcc, s2, v4
    v_lshrrev_b32 v80, 8, v80
    v_lshl_or_b32 v80, v80, 20, v84
    v_cndmask_b32 v24, v24, v80, vcc
    v_and_b32 v4, 0xff, v81
    v_cmp_eq_u32 vcc, s2, v4
    v_lshrrev_b32 v81, 8, v81
    v_lshl_or_b32 v81, v81, 20, v85
    v_cndmask_b32 v25, v25, v81, vcc
    v_and_b32 v4, 0xff, v82
    v_cmp_eq_u32 vcc, s2, v4
    v_lshrrev_b32 v82, 8, v82
    v_lshl_or_b32 v82, v82, 20, v86
    v_cndmask_b32 v26, v26, v82, vcc
    v_and_b32 v4, 0xff, v83
    v_cmp_eq_u32 vcc, s2, v4
    v_lshrrev_b32 v83, 8, v83
    v_lshl_or_b32 v83, v83, 20, v87
    v_cndmask_b32 v27, v27, v83, vcc
L_rs_done:
    s_mov_b64 exec, -1
L_reinit:
    v_mov_b32 v64, 0x7f07fff
    v_mov_b32 v65, 0x7f07fff
    v_mov_b32 v66, 0x7f07fff
    v_mov_b32 v67, 0x7f07fff
    v_add_u32 v7, 139520, v1
    ds_write_b128 v7, v[64:67]
    v_cmp_gt_u32 vcc, 256, v0
    s_and_b64 exec, exec, vcc
    ds_write_b128 v7, v[64:67] offset:16384
    v_cmp_gt_u32 vcc, 16, v0
    s_and_b64 exec, exec, vcc
    v_subrev_u32 v7, 1280, v118
    ds_write_b32 v23, v7 offset:8192
    v_cmp_eq_u32 vcc, 0, v0
    s_and_b64 exec, exec, vcc
    v_mov_b32 v5, 0
    v_mov_b32 v7, s61
    ds_write_b32 v5, v7 offset:8256
    s_cmp_eq_u32 s56, -1
    s_cbranch_scc1 L_nopop
    s_and_b32 s76, s56, 31
    s_lshl_b32 s76, 1, s76
    s_lshr_b32 s77, s56, 5
    s_lshl_b32 s77, s77, 2
    v_mov_b32 v4, s77
    v_mov_b32 v7, s76
    ds_xor_b32 v4, v7 offset:8320
L_nopop:
    s_mov_b64 exec, -1
    v_bfe_u32 v4, v0, 3, 3
    v_lshlrev_b32 v5, 2, v4
    v_add_u32 v14, s54, v5
    v_lshlrev_b32 v5, 4, v4
    v_add_u32 v15, s54, v5
    v_mov_b32 v81, v16
    v_mov_b32 v83, v17
    v_mov_b32 v85, v16
    v_mov_b32 v87, v17
    s_movk_i32 s76, 320
    v_mov_b32 v6, 140800
    s_mov_b64 s[72:73], 0
    s_waitcnt lgkmcnt(0)
    s_barrier
    v_bfe_u32 v4, v24, 18, 6
    v_mad_u32_u24 v5, v4, s76, v6
    v_cmpx_gt_u32_e64 s[56:57], s49, v24
    ds_add_rtn_u32 v4, v4, v2 offset:8192
    s_waitcnt lgkmcnt(0)
    v_cmpx_lt_u32_e64 s[58:59], v4, v5
    ds_write_b32 v4, v24
    v_mov_b32 v24, s49
    s_mov_b64 exec, -1
    s_andn2_b64 s[56:57], s[56:57], s[58:59]
    s_or_b64 s[72:73], s[72:73], s[56:57]
    v_bfe_u32 v4, v25, 18, 6
    v_mad_u32_u24 v5, v4, s76, v6
    v_cmpx_gt_u32_e64 s[56:57], s49, v25
    ds_add_rtn_u32 v4, v4, v2 offset:8192
    s_waitcnt lgkmcnt(0)
    v_cmpx_lt_u32_e64 s[58:59], v4, v5
    ds_write_b32 v4, v25
    v_mov_b32 v25, s49
    s_mov_b64 exec, -1
    s_andn2_b64 s[56:57], s[56:57], s[58:59]
    s_or_b64 s[72:73], s[72:73], s[56:57]
    v_bfe_u32 v4, v26, 18, 6
    v_mad_u32_u24 v5, v4, s76, v6
    v_cmpx_gt_u32_e64 s[56:57], s49, v26
    ds_add_rtn_u32 v4, v4, v2 offset:8192
    s_waitcnt lgkmcnt(0)
    v_cmpx_lt_u32_e64 s[58:59], v4, v5
    ds_write_b32 v4, v26
    v_mov_b32 v26, s49
    s_mov_b64 exec, -1
    s_andn2_b64 s[56:57], s[56:57], s[58:59]
    s_or_b64 s[72:73], s[72:73], s[56:57]
    v_bfe_u32 v4, v27, 18, 6
    v_mad_u32_u24 v5, v4, s76, v6
    v_cmpx_gt_u32_e64 s[56:57], s49, v27
    ds_add_rtn_u32 v4, v4, v2 offset:8192
    s_waitcnt lgkmcnt(0)
    v_cmpx_lt_u32_e64 s[58:59], v4, v5
    ds_write_b32 v4, v27
    v_mov_b32 v27, s49
    s_mov_b64 exec, -1
    s_andn2_b64 s[56:57], s[56:57], s[58:59]
    s_or_b64 s[72:73], s[72:73], s[56:57]
    v_bfe_u32 v4, v28, 18, 6
    v_mad_u32_u24 v5, v4, s76, v6
    v_cmpx_gt_u32_e64 s[56:57], s49, v28
    ds_add_rtn_u32 v4, v4, v2 offset:8192
    s_waitcnt lgkmcnt(0)
    v_cmpx_lt_u32_e64 s[58:59], v4, v5
    ds_write_b32 v4, v28
    v_mov_b32 v28, s49
    s_mov_b64 exec, -1
    s_andn2_b64 s[56:57], s[56:57], s[58:59]
    s_or_b64 s[72:73], s[72:73], s[56:57]
    v_bfe_u32 v4, v29, 18, 6
    v_mad_u32_u24 v5, v4, s76, v6
    v_cmpx_gt_u32_e64 s[56:57], s49, v29
    ds_add_rtn_u32 v4, v4, v2 offset:8192
    s_waitcnt lgkmcnt(0)
    v_cmpx_lt_u32_e64 s[58:59], v4, v5
    ds_write_b32 v4, v29
    v_mov_b32 v29, s49
    s_mov_b64 exec, -1
    s_andn2_b64 s[56:57], s[56:57], s[58:59]
    s_or_b64 s[72:73], s[72:73], s[56:57]
    v_bfe_u32 v4, v30, 18, 6
    v_mad_u32_u24 v5, v4, s76, v6
    v_cmpx_gt_u32_e64 s[56:57], s49, v30
    ds_add_rtn_u32 v4, v4, v2 offset:8192
    s_waitcnt lgkmcnt(0)
    v_cmpx_lt_u32_e64 s[58:59], v4, v5
    ds_write_b32 v4, v30
    v_mov_b32 v30, s49
    s_mov_b64 exec, -1
    s_andn2_b64 s[56:57], s[56:57], s[58:59]
    s_or_b64 s[72:73], s[72:73], s[56:57]
    v_bfe_u32 v4, v31, 18, 6
    v_mad_u32_u24 v5, v4, s76, v6
    v_cmpx_gt_u32_e64 s[56:57], s49, v31
    ds_add_rtn_u32 v4, v4, v2 offset:8192
    s_waitcnt lgkmcnt(0)
    v_cmpx_lt_u32_e64 s[58:59], v4, v5
    ds_write_b32 v4, v31
    v_mov_b32 v31, s49
    s_mov_b64 exec, -1
    s_andn2_b64 s[56:57], s[56:57], s[58:59]
    s_or_b64 s[72:73], s[72:73], s[56:57]
    s_cbranch_scc0 L_noleft
    v_mov_b32 v4, 0
    v_mov_b32 v5, 1
    ds_or_b32 v4, v5 offset:8256
L_noleft:
    s_mov_b32 s53, 0
    s_mov_b32 m0, s50
    s_waitcnt vmcnt(0) lgkmcnt(0)
    s_barrier
    ds_read_b32 v4, v23 offset:8192
    ds_read_u16 v100, v14 offset:0
    ds_read_u16 v102, v14 offset:32
    ds_read_u16 v104, v14 offset:64
    ds_read_u16 v106, v14 offset:96
    ds_read_u16 v80, v14 offset:128
    ds_read_u16 v82, v14 offset:160
    ds_read_u16 v84, v14 offset:192
    ds_read_u16 v86, v14 offset:224
    ds_read_b128 v[96:99], v15
    s_waitcnt lgkmcnt(0)
    v_readlane_b32 s60, v4, s3
    v_readlane_b32 s55, v4, 16
    s_add_u32 s76, s54, 1280
    s_min_u32 s60, s60, s76
    s_branch L_goL

.section .rodata,"a"
.p2align 6
.amdhsa_kernel standalone__kernel_systems_refs_featgraph__graph_kernel
  .amdhsa_next_free_vgpr 128
  .amdhsa_next_free_sgpr 84
  .amdhsa_accum_offset 128
  .amdhsa_group_segment_fixed_size 0
  .amdhsa_kernarg_size 64
  .amdhsa_user_sgpr_count 2
  .amdhsa_user_sgpr_kernarg_segment_ptr 1
  .amdhsa_system_sgpr_workgroup_id_x 1
.end_amdhsa_kernel
```
